```python
import torch

def _softmax(x, axis=-1):
    return torch.softmax(x, dim=axis)
def _gelu(x):
    return torch.nn.functional.gelu(x, approximate="tanh")
def _silu(x):
    return torch.nn.functional.silu(x)
def _sigmoid(x):
    return torch.sigmoid(x)
def _layernorm(x, axis=-1, eps=1e-5):
    m = x.mean(dim=axis, keepdim=True)
    v = x.var(dim=axis, keepdim=True, unbiased=False)
    return (x - m) / torch.sqrt(v + eps)
def _scatter_add(tgt, idx, src, axis=0):
    return tgt.clone().index_add_(axis, idx, src)
def _segment_sum(src, seg, n):
    out = torch.zeros((n,) + src.shape[1:], dtype=src.dtype)
    return out.index_add_(0, seg, src)
def _pad(x, pw):
    flat = tuple(v for pair in reversed(pw) for v in pair)
    return torch.nn.functional.pad(x, flat)

kernel_name = 'standalone__gqa_softmax__decode'

def setup_inputs():

    _w = (lambda a: (lambda t: t.to(torch.bfloat16) if t.is_floating_point() else t)(torch.as_tensor(a)))
    B, Hq, Hkv, Sq, Sk, D = 2, 32, 32, 1, 4096, 128
    return {
        "q": _w((lambda *s: torch.randn(*s, dtype=torch.bfloat16) * 0.8)(B, Hq, Sq, D)),
        "k": _w((lambda *s: torch.randn(*s, dtype=torch.bfloat16) * 0.8)(B, Hkv, Sk, D)),
        "v": _w((lambda *s: torch.randn(*s, dtype=torch.bfloat16) * 0.05)(B, Hkv, Sk, D)),
    }

def reference(q, k, v):
    B, Hq, Sq, D = q.shape
    Hkv = k.shape[1]
    rep = Hq // Hkv
    k = (lambda x, n, axis: torch.repeat_interleave(x, n, dim=axis))(k, rep, axis=1)
    v = (lambda x, n, axis: torch.repeat_interleave(x, n, dim=axis))(v, rep, axis=1)
    scale = D ** -0.5
    scores = torch.einsum("bhqd,bhkd->bhqk", q, k) * scale
    p = _softmax(scores, axis=-1)
    return torch.einsum("bhqk,bhkd->bhqd", p, v)
```

```asm
; @launch grid=(256,1,1) block=(256,1,1) lds=2080
.amdgcn_target "amdgcn-amd-amdhsa--gfx950"
.text
.globl standalone__gqa_softmax__decode_kernel
.p2align 8
.type standalone__gqa_softmax__decode_kernel,@function
standalone__gqa_softmax__decode_kernel:
    s_cmp_ge_u32 s2, 256
    s_cbranch_scc1 L_exit
    s_load_dwordx2 s[24:25], s[0:1], 8
    s_load_dwordx2 s[4:5], s[0:1], 0
    s_load_dwordx2 s[28:29], s[0:1], 16
    s_load_dwordx2 s[10:11], s[0:1], 24
    s_load_dwordx4 s[12:15], s[0:1], 32
    v_lshrrev_b32 v61, 6, v0
    v_and_b32 v1, 15, v0
    v_readfirstlane_b32 s18, v61
    v_lshlrev_b32 v1, 4, v1
    v_bfe_u32 v62, v0, 4, 1
    v_bfe_u32 v63, v0, 5, 1
    s_mov_b32 s21, 0x3e0293ee
    s_mov_b32 s98, 0xffff0000
    s_mov_b32 s26, 0x4000000
    s_mov_b32 s27, 0x20000
    s_mov_b32 s30, 0x4000000
    s_mov_b32 s31, 0x20000
    s_mov_b32 s56, 262400
    s_mov_b32 s57, 131328
    s_mov_b32 s58, 327936
    s_mov_b32 s59, 65792
    s_mov_b32 s60, 721152
    s_mov_b32 s61, 974848
    s_mov_b32 s23, 0
    s_bitcmp1_b32 s18, 0
    s_cselect_b32 s19, 237824, 0
    s_xor_b32 s23, s23, s19
    s_bitcmp1_b32 s18, 1
    s_cselect_b32 s19, 270848, 0
    s_xor_b32 s23, s23, s19
    s_bitcmp1_b32 s2, 0
    s_cselect_b32 s19, 98967808, 0
    s_xor_b32 s23, s23, s19
    s_bitcmp1_b32 s2, 1
    s_cselect_b32 s19, 51274240, 0
    s_xor_b32 s23, s23, s19
    s_bitcmp1_b32 s2, 2
    s_cselect_b32 s19, 13435648, 0
    s_xor_b32 s23, s23, s19
    s_bitcmp1_b32 s2, 3
    s_cselect_b32 s19, 134512640, 0
    s_xor_b32 s23, s23, s19
    s_bitcmp1_b32 s2, 4
    s_cselect_b32 s19, 14025472, 0
    s_xor_b32 s23, s23, s19
    s_bitcmp1_b32 s2, 5
    s_cselect_b32 s19, 31359232, 0
    s_xor_b32 s23, s23, s19
    s_bitcmp1_b32 s2, 6
    s_cselect_b32 s19, 25837568, 0
    s_xor_b32 s23, s23, s19
    s_bitcmp1_b32 s2, 7
    s_cselect_b32 s19, 28773120, 0
    s_xor_b32 s23, s23, s19
    s_bfe_u32 s17, s23, 131098
    s_and_b32 s23, s23, 0x3ffffff
    s_lshr_b32 s16, s23, 20
    s_lshl_b32 s19, s16, 8
    v_add_u32 v61, s19, v1
    v_lshlrev_b32 v62, 12, v62
    v_lshlrev_b32 v63, 10, v63
    s_lshl_b32 s19, s16, 2
    s_add_u32 s19, s19, s17
    s_lshl_b32 s19, s19, 10
    v_and_b32 v65, 63, v0
    v_bfe_u32 v69, v0, 4, 2
    v_lshlrev_b32 v69, 2, v69
    v_add_u32 v69, v69, v1
    v_or3_b32 v1, v1, v62, v63
    v_lshl_add_u32 v65, v65, 4, s19
    s_waitcnt lgkmcnt(0)
    global_load_dwordx4 v[2:5], v61, s[4:5]
    s_mov_b32 s22, s23
    buffer_load_dwordx4 v[100:103], v1, s[24:27], s22 offen nt
    s_xor_b32 s22, s22, s56
    buffer_load_dwordx4 v[104:107], v1, s[24:27], s22 offen nt
    s_xor_b32 s22, s22, s57
    buffer_load_dwordx4 v[108:111], v1, s[24:27], s22 offen nt
    s_xor_b32 s22, s22, s56
    buffer_load_dwordx4 v[112:115], v1, s[24:27], s22 offen nt
    s_xor_b32 s22, s22, s58
    buffer_load_dwordx4 v[116:119], v1, s[24:27], s22 offen nt
    s_xor_b32 s22, s22, s56
    buffer_load_dwordx4 v[120:123], v1, s[24:27], s22 offen nt
    s_xor_b32 s22, s22, s57
    buffer_load_dwordx4 v[124:127], v1, s[24:27], s22 offen nt
    s_xor_b32 s22, s22, s56
    buffer_load_dwordx4 v[128:131], v1, s[24:27], s22 offen nt
    s_xor_b32 s22, s22, s59
    buffer_load_dwordx4 v[132:135], v1, s[24:27], s22 offen nt
    s_xor_b32 s22, s22, s56
    buffer_load_dwordx4 v[136:139], v1, s[24:27], s22 offen nt
    s_xor_b32 s22, s22, s57
    buffer_load_dwordx4 v[140:143], v1, s[24:27], s22 offen nt
    s_xor_b32 s22, s22, s56
    buffer_load_dwordx4 v[144:147], v1, s[24:27], s22 offen nt
    s_xor_b32 s22, s22, s58
    buffer_load_dwordx4 v[148:151], v1, s[24:27], s22 offen nt
    s_xor_b32 s22, s22, s56
    buffer_load_dwordx4 v[152:155], v1, s[24:27], s22 offen nt
    s_xor_b32 s22, s22, s57
    buffer_load_dwordx4 v[156:159], v1, s[24:27], s22 offen nt
    s_xor_b32 s22, s22, s56
    buffer_load_dwordx4 v[160:163], v1, s[24:27], s22 offen nt
    s_mov_b32 s32, s24
    s_mov_b32 s33, s25
    s_mov_b32 s34, 0x4000000
    s_mov_b32 s35, 0x20000
    s_mov_b32 s63, s60
    s_xor_b32 s54, s60, s61
    s_mov_b32 s62, 0
    s_cmp_lg_u32 s18, 0
    s_cbranch_scc1 L_noclrr
    v_mov_b32 v72, 0
    v_mov_b32 v73, 0
    v_mov_b32 v74, 0
    v_mov_b32 v75, 0
    global_store_dwordx4 v65, v[72:75], s[14:15] sc1
L_noclrr:
L_kloop:
    s_cmp_lg_u32 s62, 3
    s_cbranch_scc1 L_knosw
    s_mov_b32 s32, s28
    s_mov_b32 s33, s29
L_knosw:
    s_waitcnt vmcnt(15)
    v_dot2_f32_bf16 v6, v100, v2, 0
    v_dot2_f32_bf16 v6, v101, v3, v6
    v_dot2_f32_bf16 v6, v102, v4, v6
    v_dot2_f32_bf16 v6, v103, v5, v6
    s_xor_b32 s22, s22, s63
    buffer_load_dwordx4 v[100:103], v1, s[32:35], s22 offen nt
    s_waitcnt vmcnt(15)
    v_dot2_f32_bf16 v7, v104, v2, 0
    v_dot2_f32_bf16 v7, v105, v3, v7
    v_dot2_f32_bf16 v7, v106, v4, v7
    v_dot2_f32_bf16 v7, v107, v5, v7
    s_xor_b32 s22, s22, s56
    buffer_load_dwordx4 v[104:107], v1, s[32:35], s22 offen nt
    s_waitcnt vmcnt(15)
    v_dot2_f32_bf16 v8, v108, v2, 0
    v_dot2_f32_bf16 v8, v109, v3, v8
    v_dot2_f32_bf16 v8, v110, v4, v8
    v_dot2_f32_bf16 v8, v111, v5, v8
    s_xor_b32 s22, s22, s57
    buffer_load_dwordx4 v[108:111], v1, s[32:35], s22 offen nt
    s_waitcnt vmcnt(15)
    v_dot2_f32_bf16 v9, v112, v2, 0
    v_dot2_f32_bf16 v9, v113, v3, v9
    v_dot2_f32_bf16 v9, v114, v4, v9
    v_dot2_f32_bf16 v9, v115, v5, v9
    s_xor_b32 s22, s22, s56
    buffer_load_dwordx4 v[112:115], v1, s[32:35], s22 offen nt
    s_waitcnt vmcnt(15)
    v_dot2_f32_bf16 v10, v116, v2, 0
    v_dot2_f32_bf16 v10, v117, v3, v10
    v_dot2_f32_bf16 v10, v118, v4, v10
    v_dot2_f32_bf16 v10, v119, v5, v10
    s_xor_b32 s22, s22, s58
    buffer_load_dwordx4 v[116:119], v1, s[32:35], s22 offen nt
    s_waitcnt vmcnt(15)
    v_dot2_f32_bf16 v11, v120, v2, 0
    v_dot2_f32_bf16 v11, v121, v3, v11
    v_dot2_f32_bf16 v11, v122, v4, v11
    v_dot2_f32_bf16 v11, v123, v5, v11
    s_xor_b32 s22, s22, s56
    buffer_load_dwordx4 v[120:123], v1, s[32:35], s22 offen nt
    s_waitcnt vmcnt(15)
    v_dot2_f32_bf16 v12, v124, v2, 0
    v_dot2_f32_bf16 v12, v125, v3, v12
    v_dot2_f32_bf16 v12, v126, v4, v12
    v_dot2_f32_bf16 v12, v127, v5, v12
    s_xor_b32 s22, s22, s57
    buffer_load_dwordx4 v[124:127], v1, s[32:35], s22 offen nt
    s_waitcnt vmcnt(15)
    v_dot2_f32_bf16 v13, v128, v2, 0
    v_dot2_f32_bf16 v13, v129, v3, v13
    v_dot2_f32_bf16 v13, v130, v4, v13
    v_dot2_f32_bf16 v13, v131, v5, v13
    s_xor_b32 s22, s22, s56
    buffer_load_dwordx4 v[128:131], v1, s[32:35], s22 offen nt
    s_waitcnt vmcnt(15)
    v_dot2_f32_bf16 v14, v132, v2, 0
    v_dot2_f32_bf16 v14, v133, v3, v14
    v_dot2_f32_bf16 v14, v134, v4, v14
    v_dot2_f32_bf16 v14, v135, v5, v14
    s_xor_b32 s22, s22, s59
    buffer_load_dwordx4 v[132:135], v1, s[32:35], s22 offen nt
    s_waitcnt vmcnt(15)
    v_dot2_f32_bf16 v15, v136, v2, 0
    v_dot2_f32_bf16 v15, v137, v3, v15
    v_dot2_f32_bf16 v15, v138, v4, v15
    v_dot2_f32_bf16 v15, v139, v5, v15
    s_xor_b32 s22, s22, s56
    buffer_load_dwordx4 v[136:139], v1, s[32:35], s22 offen nt
    s_waitcnt vmcnt(15)
    v_dot2_f32_bf16 v16, v140, v2, 0
    v_dot2_f32_bf16 v16, v141, v3, v16
    v_dot2_f32_bf16 v16, v142, v4, v16
    v_dot2_f32_bf16 v16, v143, v5, v16
    s_xor_b32 s22, s22, s57
    buffer_load_dwordx4 v[140:143], v1, s[32:35], s22 offen nt
    s_waitcnt vmcnt(15)
    v_dot2_f32_bf16 v17, v144, v2, 0
    v_dot2_f32_bf16 v17, v145, v3, v17
    v_dot2_f32_bf16 v17, v146, v4, v17
    v_dot2_f32_bf16 v17, v147, v5, v17
    s_xor_b32 s22, s22, s56
    buffer_load_dwordx4 v[144:147], v1, s[32:35], s22 offen nt
    s_waitcnt vmcnt(15)
    v_dot2_f32_bf16 v18, v148, v2, 0
    v_dot2_f32_bf16 v18, v149, v3, v18
    v_dot2_f32_bf16 v18, v150, v4, v18
    v_dot2_f32_bf16 v18, v151, v5, v18
    s_xor_b32 s22, s22, s58
    buffer_load_dwordx4 v[148:151], v1, s[32:35], s22 offen nt
    s_waitcnt vmcnt(15)
    v_dot2_f32_bf16 v19, v152, v2, 0
    v_dot2_f32_bf16 v19, v153, v3, v19
    v_dot2_f32_bf16 v19, v154, v4, v19
    v_dot2_f32_bf16 v19, v155, v5, v19
    s_xor_b32 s22, s22, s56
    buffer_load_dwordx4 v[152:155], v1, s[32:35], s22 offen nt
    s_waitcnt vmcnt(15)
    v_dot2_f32_bf16 v20, v156, v2, 0
    v_dot2_f32_bf16 v20, v157, v3, v20
    v_dot2_f32_bf16 v20, v158, v4, v20
    v_dot2_f32_bf16 v20, v159, v5, v20
    s_xor_b32 s22, s22, s57
    buffer_load_dwordx4 v[156:159], v1, s[32:35], s22 offen nt
    s_waitcnt vmcnt(15)
    v_dot2_f32_bf16 v21, v160, v2, 0
    v_dot2_f32_bf16 v21, v161, v3, v21
    v_dot2_f32_bf16 v21, v162, v4, v21
    v_dot2_f32_bf16 v21, v163, v5, v21
    s_xor_b32 s22, s22, s56
    buffer_load_dwordx4 v[160:163], v1, s[32:35], s22 offen nt
    s_xor_b32 s63, s63, s54
    v_mov_b32 v22, v26
    v_mov_b32 v23, v27
    v_mov_b32 v24, v28
    v_add_f32_dpp v6, v6, v6 row_ror:8 row_mask:0xf bank_mask:0x3
    v_add_f32_dpp v7, v7, v7 row_ror:8 row_mask:0xf bank_mask:0x3
    v_add_f32_dpp v8, v8, v8 row_ror:8 row_mask:0xf bank_mask:0x3
    v_add_f32_dpp v9, v9, v9 row_ror:8 row_mask:0xf bank_mask:0x3
    v_add_f32_dpp v10, v10, v10 row_ror:8 row_mask:0xf bank_mask:0x3
    v_add_f32_dpp v11, v11, v11 row_ror:8 row_mask:0xf bank_mask:0x3
    v_add_f32_dpp v12, v12, v12 row_ror:8 row_mask:0xf bank_mask:0x3
    v_add_f32_dpp v13, v13, v13 row_ror:8 row_mask:0xf bank_mask:0x3
    v_mov_b32 v25, v29
    v_mov_b32 v26, v30
    v_mov_b32 v27, v31
    v_mov_b32 v28, v32
    v_mov_b32 v29, v33
    v_mov_b32 v30, v34
    v_mov_b32 v31, v35
    v_mov_b32 v32, v36
    v_mov_b32 v33, v37
    v_add_f32_dpp v6, v14, v14 row_ror:8 row_mask:0xf bank_mask:0xc
    v_add_f32_dpp v7, v15, v15 row_ror:8 row_mask:0xf bank_mask:0xc
    v_add_f32_dpp v8, v16, v16 row_ror:8 row_mask:0xf bank_mask:0xc
    v_add_f32_dpp v9, v17, v17 row_ror:8 row_mask:0xf bank_mask:0xc
    v_add_f32_dpp v10, v18, v18 row_ror:8 row_mask:0xf bank_mask:0xc
    v_add_f32_dpp v11, v19, v19 row_ror:8 row_mask:0xf bank_mask:0xc
    v_add_f32_dpp v12, v20, v20 row_ror:8 row_mask:0xf bank_mask:0xc
    v_add_f32_dpp v13, v21, v21 row_ror:8 row_mask:0xf bank_mask:0xc
    v_add_f32_dpp v6, v6, v6 row_half_mirror row_mask:0xf bank_mask:0x5
    v_add_f32_dpp v7, v7, v7 row_half_mirror row_mask:0xf bank_mask:0x5
    v_add_f32_dpp v8, v8, v8 row_half_mirror row_mask:0xf bank_mask:0x5
    v_add_f32_dpp v9, v9, v9 row_half_mirror row_mask:0xf bank_mask:0x5
    v_add_f32_dpp v6, v10, v10 row_half_mirror row_mask:0xf bank_mask:0xa
    v_add_f32_dpp v7, v11, v11 row_half_mirror row_mask:0xf bank_mask:0xa
    v_add_f32_dpp v8, v12, v12 row_half_mirror row_mask:0xf bank_mask:0xa
    v_add_f32_dpp v9, v13, v13 row_half_mirror row_mask:0xf bank_mask:0xa
    v_add_f32_dpp v6, v6, v6 quad_perm:[1,0,3,2] row_mask:0xf bank_mask:0xf
    v_add_f32_dpp v7, v7, v7 quad_perm:[1,0,3,2] row_mask:0xf bank_mask:0xf
    v_add_f32_dpp v8, v8, v8 quad_perm:[1,0,3,2] row_mask:0xf bank_mask:0xf
    v_add_f32_dpp v9, v9, v9 quad_perm:[1,0,3,2] row_mask:0xf bank_mask:0xf
    v_add_f32_dpp v6, v6, v6 quad_perm:[2,3,0,1] row_mask:0xf bank_mask:0xf
    v_add_f32_dpp v7, v7, v7 quad_perm:[2,3,0,1] row_mask:0xf bank_mask:0xf
    v_add_f32_dpp v8, v8, v8 quad_perm:[2,3,0,1] row_mask:0xf bank_mask:0xf
    v_add_f32_dpp v9, v9, v9 quad_perm:[2,3,0,1] row_mask:0xf bank_mask:0xf
    s_add_u32 s62, s62, 1
    v_mul_f32 v34, s21, v6
    v_mul_f32 v35, s21, v7
    v_mul_f32 v36, s21, v8
    v_mul_f32 v37, s21, v9
    s_cmp_lt_u32 s62, 4
    s_cbranch_scc1 L_kloop
    v_max_f32 v58, v22, v23
    v_max3_f32 v58, v58, v24, v25
    v_max3_f32 v58, v58, v26, v27
    v_max3_f32 v58, v58, v28, v29
    v_max3_f32 v58, v58, v30, v31
    v_max3_f32 v58, v58, v32, v33
    v_max3_f32 v58, v58, v34, v35
    v_max3_f32 v58, v58, v36, v37
    s_nop 1
    v_max_f32_dpp v58, v58, v58 row_ror:4 row_mask:0xf bank_mask:0xf
    s_nop 1
    v_max_f32_dpp v58, v58, v58 row_ror:8 row_mask:0xf bank_mask:0xf
    s_nop 0
    v_mov_b32 v61, v58
    s_nop 1
    v_permlane16_swap_b32 v58, v61
    s_nop 0
    v_max_f32 v58, v58, v61
    s_nop 0
    v_mov_b32 v61, v58
    s_nop 1
    v_permlane32_swap_b32 v58, v61
    s_nop 0
    v_max_f32 v58, v58, v61
    v_sub_f32 v22, v22, v58
    v_sub_f32 v23, v23, v58
    v_sub_f32 v24, v24, v58
    v_sub_f32 v25, v25, v58
    v_sub_f32 v26, v26, v58
    v_sub_f32 v27, v27, v58
    v_sub_f32 v28, v28, v58
    v_sub_f32 v29, v29, v58
    v_sub_f32 v30, v30, v58
    v_sub_f32 v31, v31, v58
    v_sub_f32 v32, v32, v58
    v_sub_f32 v33, v33, v58
    v_sub_f32 v34, v34, v58
    v_sub_f32 v35, v35, v58
    v_sub_f32 v36, v36, v58
    v_sub_f32 v37, v37, v58
    v_exp_f32 v22, v22
    v_exp_f32 v23, v23
    v_exp_f32 v24, v24
    v_exp_f32 v25, v25
    v_exp_f32 v26, v26
    v_exp_f32 v27, v27
    v_exp_f32 v28, v28
    v_exp_f32 v29, v29
    v_exp_f32 v30, v30
    v_exp_f32 v31, v31
    v_exp_f32 v32, v32
    v_exp_f32 v33, v33
    v_exp_f32 v34, v34
    v_exp_f32 v35, v35
    v_exp_f32 v36, v36
    v_exp_f32 v37, v37
    s_nop 0
    v_add_f32 v59, v22, v23
    v_add_f32 v59, v59, v24
    v_add_f32 v59, v59, v25
    v_add_f32 v59, v59, v26
    v_add_f32 v59, v59, v27
    v_add_f32 v59, v59, v28
    v_add_f32 v59, v59, v29
    v_add_f32 v59, v59, v30
    v_add_f32 v59, v59, v31
    v_add_f32 v59, v59, v32
    v_add_f32 v59, v59, v33
    v_add_f32 v59, v59, v34
    v_add_f32 v59, v59, v35
    v_add_f32 v59, v59, v36
    v_add_f32 v59, v59, v37
    v_mov_b32 v42, 0
    v_mov_b32 v43, 0
    v_mov_b32 v44, 0
    v_mov_b32 v45, 0
    v_mov_b32 v46, 0
    v_mov_b32 v47, 0
    v_mov_b32 v48, 0
    v_mov_b32 v49, 0
    s_nop 1
    v_add_f32_dpp v59, v59, v59 row_ror:4 row_mask:0xf bank_mask:0xf
    s_nop 1
    v_add_f32_dpp v59, v59, v59 row_ror:8 row_mask:0xf bank_mask:0xf
    s_nop 0
    v_mov_b32 v61, v59
    s_nop 1
    v_permlane16_swap_b32 v59, v61
    s_nop 0
    v_add_f32 v59, v59, v61
    s_nop 0
    v_mov_b32 v61, v59
    s_nop 1
    v_permlane32_swap_b32 v59, v61
    s_nop 0
    v_add_f32 v59, v59, v61
    s_lshl_b32 s19, s18, 3
    s_add_u32 s19, s19, 2048
    v_mov_b32 v62, s19
    v_lshlrev_b32 v64, 3, v0
    ds_write_b64 v62, v[58:59]
    s_mov_b32 s62, 0
    s_waitcnt lgkmcnt(0)
    s_barrier
    v_mov_b32 v62, 2048
    ds_read_b128 v[6:9], v62
    ds_read_b128 v[10:13], v62 offset:16
    s_waitcnt lgkmcnt(0)
    v_max_f32 v67, v6, v8
    v_max3_f32 v67, v67, v10, v12
    v_sub_f32 v6, v6, v67
    v_sub_f32 v8, v8, v67
    v_sub_f32 v10, v10, v67
    v_sub_f32 v12, v12, v67
    v_sub_f32 v60, v58, v67
    v_exp_f32 v6, v6
    v_exp_f32 v8, v8
    v_exp_f32 v10, v10
    v_exp_f32 v12, v12
    v_exp_f32 v60, v60
    v_mul_f32 v68, v6, v7
    v_fmac_f32 v68, v8, v9
    v_fmac_f32 v68, v10, v11
    v_fmac_f32 v68, v12, v13
L_vloop:
    s_waitcnt vmcnt(15)
    v_mov_b32_dpp v96, v22 row_newbcast:0 row_mask:0xf bank_mask:0xf
    v_lshlrev_b32 v50, 16, v100
    v_and_b32 v51, s98, v100
    v_lshlrev_b32 v52, 16, v101
    v_and_b32 v53, s98, v101
    v_lshlrev_b32 v54, 16, v102
    v_and_b32 v55, s98, v102
    v_lshlrev_b32 v56, 16, v103
    v_and_b32 v57, s98, v103
    s_xor_b32 s22, s22, s63
    buffer_load_dwordx4 v[100:103], v1, s[32:35], s22 offen nt
    v_pk_fma_f32 v[42:43], v[50:51], v[96:97], v[42:43] op_sel_hi:[1,0,1]
    v_pk_fma_f32 v[44:45], v[52:53], v[96:97], v[44:45] op_sel_hi:[1,0,1]
    v_pk_fma_f32 v[46:47], v[54:55], v[96:97], v[46:47] op_sel_hi:[1,0,1]
    v_pk_fma_f32 v[48:49], v[56:57], v[96:97], v[48:49] op_sel_hi:[1,0,1]
    s_waitcnt vmcnt(15)
    v_mov_b32_dpp v96, v23 row_newbcast:0 row_mask:0xf bank_mask:0xf
    v_lshlrev_b32 v50, 16, v104
    v_and_b32 v51, s98, v104
    v_lshlrev_b32 v52, 16, v105
    v_and_b32 v53, s98, v105
    v_lshlrev_b32 v54, 16, v106
    v_and_b32 v55, s98, v106
    v_lshlrev_b32 v56, 16, v107
    v_and_b32 v57, s98, v107
    s_xor_b32 s22, s22, s56
    buffer_load_dwordx4 v[104:107], v1, s[32:35], s22 offen nt
    v_pk_fma_f32 v[42:43], v[50:51], v[96:97], v[42:43] op_sel_hi:[1,0,1]
    v_pk_fma_f32 v[44:45], v[52:53], v[96:97], v[44:45] op_sel_hi:[1,0,1]
    v_pk_fma_f32 v[46:47], v[54:55], v[96:97], v[46:47] op_sel_hi:[1,0,1]
    v_pk_fma_f32 v[48:49], v[56:57], v[96:97], v[48:49] op_sel_hi:[1,0,1]
    s_waitcnt vmcnt(15)
    v_mov_b32_dpp v96, v24 row_newbcast:0 row_mask:0xf bank_mask:0xf
    v_lshlrev_b32 v50, 16, v108
    v_and_b32 v51, s98, v108
    v_lshlrev_b32 v52, 16, v109
    v_and_b32 v53, s98, v109
    v_lshlrev_b32 v54, 16, v110
    v_and_b32 v55, s98, v110
    v_lshlrev_b32 v56, 16, v111
    v_and_b32 v57, s98, v111
    s_xor_b32 s22, s22, s57
    buffer_load_dwordx4 v[108:111], v1, s[32:35], s22 offen nt
    v_pk_fma_f32 v[42:43], v[50:51], v[96:97], v[42:43] op_sel_hi:[1,0,1]
    v_pk_fma_f32 v[44:45], v[52:53], v[96:97], v[44:45] op_sel_hi:[1,0,1]
    v_pk_fma_f32 v[46:47], v[54:55], v[96:97], v[46:47] op_sel_hi:[1,0,1]
    v_pk_fma_f32 v[48:49], v[56:57], v[96:97], v[48:49] op_sel_hi:[1,0,1]
    s_waitcnt vmcnt(15)
    v_mov_b32_dpp v96, v25 row_newbcast:0 row_mask:0xf bank_mask:0xf
    v_lshlrev_b32 v50, 16, v112
    v_and_b32 v51, s98, v112
    v_lshlrev_b32 v52, 16, v113
    v_and_b32 v53, s98, v113
    v_lshlrev_b32 v54, 16, v114
    v_and_b32 v55, s98, v114
    v_lshlrev_b32 v56, 16, v115
    v_and_b32 v57, s98, v115
    s_xor_b32 s22, s22, s56
    buffer_load_dwordx4 v[112:115], v1, s[32:35], s22 offen nt
    v_pk_fma_f32 v[42:43], v[50:51], v[96:97], v[42:43] op_sel_hi:[1,0,1]
    v_pk_fma_f32 v[44:45], v[52:53], v[96:97], v[44:45] op_sel_hi:[1,0,1]
    v_pk_fma_f32 v[46:47], v[54:55], v[96:97], v[46:47] op_sel_hi:[1,0,1]
    v_pk_fma_f32 v[48:49], v[56:57], v[96:97], v[48:49] op_sel_hi:[1,0,1]
    s_waitcnt vmcnt(15)
    v_mov_b32_dpp v96, v22 row_newbcast:4 row_mask:0xf bank_mask:0xf
    v_lshlrev_b32 v50, 16, v116
    v_and_b32 v51, s98, v116
    v_lshlrev_b32 v52, 16, v117
    v_and_b32 v53, s98, v117
    v_lshlrev_b32 v54, 16, v118
    v_and_b32 v55, s98, v118
    v_lshlrev_b32 v56, 16, v119
    v_and_b32 v57, s98, v119
    s_xor_b32 s22, s22, s58
    buffer_load_dwordx4 v[116:119], v1, s[32:35], s22 offen nt
    v_pk_fma_f32 v[42:43], v[50:51], v[96:97], v[42:43] op_sel_hi:[1,0,1]
    v_pk_fma_f32 v[44:45], v[52:53], v[96:97], v[44:45] op_sel_hi:[1,0,1]
    v_pk_fma_f32 v[46:47], v[54:55], v[96:97], v[46:47] op_sel_hi:[1,0,1]
    v_pk_fma_f32 v[48:49], v[56:57], v[96:97], v[48:49] op_sel_hi:[1,0,1]
    s_waitcnt vmcnt(15)
    v_mov_b32_dpp v96, v23 row_newbcast:4 row_mask:0xf bank_mask:0xf
    v_lshlrev_b32 v50, 16, v120
    v_and_b32 v51, s98, v120
    v_lshlrev_b32 v52, 16, v121
    v_and_b32 v53, s98, v121
    v_lshlrev_b32 v54, 16, v122
    v_and_b32 v55, s98, v122
    v_lshlrev_b32 v56, 16, v123
    v_and_b32 v57, s98, v123
    s_xor_b32 s22, s22, s56
    buffer_load_dwordx4 v[120:123], v1, s[32:35], s22 offen nt
    v_pk_fma_f32 v[42:43], v[50:51], v[96:97], v[42:43] op_sel_hi:[1,0,1]
    v_pk_fma_f32 v[44:45], v[52:53], v[96:97], v[44:45] op_sel_hi:[1,0,1]
    v_pk_fma_f32 v[46:47], v[54:55], v[96:97], v[46:47] op_sel_hi:[1,0,1]
    v_pk_fma_f32 v[48:49], v[56:57], v[96:97], v[48:49] op_sel_hi:[1,0,1]
    s_waitcnt vmcnt(15)
    v_mov_b32_dpp v96, v24 row_newbcast:4 row_mask:0xf bank_mask:0xf
    v_lshlrev_b32 v50, 16, v124
    v_and_b32 v51, s98, v124
    v_lshlrev_b32 v52, 16, v125
    v_and_b32 v53, s98, v125
    v_lshlrev_b32 v54, 16, v126
    v_and_b32 v55, s98, v126
    v_lshlrev_b32 v56, 16, v127
    v_and_b32 v57, s98, v127
    s_xor_b32 s22, s22, s57
    buffer_load_dwordx4 v[124:127], v1, s[32:35], s22 offen nt
    v_pk_fma_f32 v[42:43], v[50:51], v[96:97], v[42:43] op_sel_hi:[1,0,1]
    v_pk_fma_f32 v[44:45], v[52:53], v[96:97], v[44:45] op_sel_hi:[1,0,1]
    v_pk_fma_f32 v[46:47], v[54:55], v[96:97], v[46:47] op_sel_hi:[1,0,1]
    v_pk_fma_f32 v[48:49], v[56:57], v[96:97], v[48:49] op_sel_hi:[1,0,1]
    s_waitcnt vmcnt(15)
    v_mov_b32_dpp v96, v25 row_newbcast:4 row_mask:0xf bank_mask:0xf
    v_lshlrev_b32 v50, 16, v128
    v_and_b32 v51, s98, v128
    v_lshlrev_b32 v52, 16, v129
    v_and_b32 v53, s98, v129
    v_lshlrev_b32 v54, 16, v130
    v_and_b32 v55, s98, v130
    v_lshlrev_b32 v56, 16, v131
    v_and_b32 v57, s98, v131
    s_xor_b32 s22, s22, s56
    buffer_load_dwordx4 v[128:131], v1, s[32:35], s22 offen nt
    v_pk_fma_f32 v[42:43], v[50:51], v[96:97], v[42:43] op_sel_hi:[1,0,1]
    v_pk_fma_f32 v[44:45], v[52:53], v[96:97], v[44:45] op_sel_hi:[1,0,1]
    v_pk_fma_f32 v[46:47], v[54:55], v[96:97], v[46:47] op_sel_hi:[1,0,1]
    v_pk_fma_f32 v[48:49], v[56:57], v[96:97], v[48:49] op_sel_hi:[1,0,1]
    s_waitcnt vmcnt(15)
    v_mov_b32_dpp v96, v22 row_newbcast:8 row_mask:0xf bank_mask:0xf
    v_lshlrev_b32 v50, 16, v132
    v_and_b32 v51, s98, v132
    v_lshlrev_b32 v52, 16, v133
    v_and_b32 v53, s98, v133
    v_lshlrev_b32 v54, 16, v134
    v_and_b32 v55, s98, v134
    v_lshlrev_b32 v56, 16, v135
    v_and_b32 v57, s98, v135
    s_xor_b32 s22, s22, s59
    buffer_load_dwordx4 v[132:135], v1, s[32:35], s22 offen nt
    v_pk_fma_f32 v[42:43], v[50:51], v[96:97], v[42:43] op_sel_hi:[1,0,1]
    v_pk_fma_f32 v[44:45], v[52:53], v[96:97], v[44:45] op_sel_hi:[1,0,1]
    v_pk_fma_f32 v[46:47], v[54:55], v[96:97], v[46:47] op_sel_hi:[1,0,1]
    v_pk_fma_f32 v[48:49], v[56:57], v[96:97], v[48:49] op_sel_hi:[1,0,1]
    s_waitcnt vmcnt(15)
    v_mov_b32_dpp v96, v23 row_newbcast:8 row_mask:0xf bank_mask:0xf
    v_lshlrev_b32 v50, 16, v136
    v_and_b32 v51, s98, v136
    v_lshlrev_b32 v52, 16, v137
    v_and_b32 v53, s98, v137
    v_lshlrev_b32 v54, 16, v138
    v_and_b32 v55, s98, v138
    v_lshlrev_b32 v56, 16, v139
    v_and_b32 v57, s98, v139
    s_xor_b32 s22, s22, s56
    buffer_load_dwordx4 v[136:139], v1, s[32:35], s22 offen nt
    v_pk_fma_f32 v[42:43], v[50:51], v[96:97], v[42:43] op_sel_hi:[1,0,1]
    v_pk_fma_f32 v[44:45], v[52:53], v[96:97], v[44:45] op_sel_hi:[1,0,1]
    v_pk_fma_f32 v[46:47], v[54:55], v[96:97], v[46:47] op_sel_hi:[1,0,1]
    v_pk_fma_f32 v[48:49], v[56:57], v[96:97], v[48:49] op_sel_hi:[1,0,1]
    s_waitcnt vmcnt(15)
    v_mov_b32_dpp v96, v24 row_newbcast:8 row_mask:0xf bank_mask:0xf
    v_lshlrev_b32 v50, 16, v140
    v_and_b32 v51, s98, v140
    v_lshlrev_b32 v52, 16, v141
    v_and_b32 v53, s98, v141
    v_lshlrev_b32 v54, 16, v142
    v_and_b32 v55, s98, v142
    v_lshlrev_b32 v56, 16, v143
    v_and_b32 v57, s98, v143
    s_xor_b32 s22, s22, s57
    buffer_load_dwordx4 v[140:143], v1, s[32:35], s22 offen nt
    v_pk_fma_f32 v[42:43], v[50:51], v[96:97], v[42:43] op_sel_hi:[1,0,1]
    v_pk_fma_f32 v[44:45], v[52:53], v[96:97], v[44:45] op_sel_hi:[1,0,1]
    v_pk_fma_f32 v[46:47], v[54:55], v[96:97], v[46:47] op_sel_hi:[1,0,1]
    v_pk_fma_f32 v[48:49], v[56:57], v[96:97], v[48:49] op_sel_hi:[1,0,1]
    s_waitcnt vmcnt(15)
    v_mov_b32_dpp v96, v25 row_newbcast:8 row_mask:0xf bank_mask:0xf
    v_lshlrev_b32 v50, 16, v144
    v_and_b32 v51, s98, v144
    v_lshlrev_b32 v52, 16, v145
    v_and_b32 v53, s98, v145
    v_lshlrev_b32 v54, 16, v146
    v_and_b32 v55, s98, v146
    v_lshlrev_b32 v56, 16, v147
    v_and_b32 v57, s98, v147
    s_xor_b32 s22, s22, s56
    buffer_load_dwordx4 v[144:147], v1, s[32:35], s22 offen nt
    v_pk_fma_f32 v[42:43], v[50:51], v[96:97], v[42:43] op_sel_hi:[1,0,1]
    v_pk_fma_f32 v[44:45], v[52:53], v[96:97], v[44:45] op_sel_hi:[1,0,1]
    v_pk_fma_f32 v[46:47], v[54:55], v[96:97], v[46:47] op_sel_hi:[1,0,1]
    v_pk_fma_f32 v[48:49], v[56:57], v[96:97], v[48:49] op_sel_hi:[1,0,1]
    s_waitcnt vmcnt(15)
    v_mov_b32_dpp v96, v22 row_newbcast:12 row_mask:0xf bank_mask:0xf
    v_lshlrev_b32 v50, 16, v148
    v_and_b32 v51, s98, v148
    v_lshlrev_b32 v52, 16, v149
    v_and_b32 v53, s98, v149
    v_lshlrev_b32 v54, 16, v150
    v_and_b32 v55, s98, v150
    v_lshlrev_b32 v56, 16, v151
    v_and_b32 v57, s98, v151
    s_xor_b32 s22, s22, s58
    buffer_load_dwordx4 v[148:151], v1, s[32:35], s22 offen nt
    s_cmp_lg_u32 s62, 2
    s_cbranch_scc1 L_notkr
    s_cmp_lg_u32 s18, 0
    s_cbranch_scc1 L_notkr
    s_lshl_b32 s19, s16, 2
    v_mov_b32 v62, s19
    v_mov_b32 v63, 1
    v_mov_b32 v66, -1
    s_mov_b64 exec, 1
    global_atomic_add v66, v62, v63, s[12:13] sc0
    s_mov_b64 exec, -1
L_notkr:
    v_pk_fma_f32 v[42:43], v[50:51], v[96:97], v[42:43] op_sel_hi:[1,0,1]
    v_pk_fma_f32 v[44:45], v[52:53], v[96:97], v[44:45] op_sel_hi:[1,0,1]
    v_pk_fma_f32 v[46:47], v[54:55], v[96:97], v[46:47] op_sel_hi:[1,0,1]
    v_pk_fma_f32 v[48:49], v[56:57], v[96:97], v[48:49] op_sel_hi:[1,0,1]
    s_waitcnt vmcnt(15)
    v_mov_b32_dpp v96, v23 row_newbcast:12 row_mask:0xf bank_mask:0xf
    v_lshlrev_b32 v50, 16, v152
    v_and_b32 v51, s98, v152
    v_lshlrev_b32 v52, 16, v153
    v_and_b32 v53, s98, v153
    v_lshlrev_b32 v54, 16, v154
    v_and_b32 v55, s98, v154
    v_lshlrev_b32 v56, 16, v155
    v_and_b32 v57, s98, v155
    s_xor_b32 s22, s22, s56
    buffer_load_dwordx4 v[152:155], v1, s[32:35], s22 offen nt
    v_pk_fma_f32 v[42:43], v[50:51], v[96:97], v[42:43] op_sel_hi:[1,0,1]
    v_pk_fma_f32 v[44:45], v[52:53], v[96:97], v[44:45] op_sel_hi:[1,0,1]
    v_pk_fma_f32 v[46:47], v[54:55], v[96:97], v[46:47] op_sel_hi:[1,0,1]
    v_pk_fma_f32 v[48:49], v[56:57], v[96:97], v[48:49] op_sel_hi:[1,0,1]
    s_waitcnt vmcnt(15)
    v_mov_b32_dpp v96, v24 row_newbcast:12 row_mask:0xf bank_mask:0xf
    v_lshlrev_b32 v50, 16, v156
    v_and_b32 v51, s98, v156
    v_lshlrev_b32 v52, 16, v157
    v_and_b32 v53, s98, v157
    v_lshlrev_b32 v54, 16, v158
    v_and_b32 v55, s98, v158
    v_lshlrev_b32 v56, 16, v159
    v_and_b32 v57, s98, v159
    s_xor_b32 s22, s22, s57
    buffer_load_dwordx4 v[156:159], v1, s[32:35], s22 offen nt
    v_pk_fma_f32 v[42:43], v[50:51], v[96:97], v[42:43] op_sel_hi:[1,0,1]
    v_pk_fma_f32 v[44:45], v[52:53], v[96:97], v[44:45] op_sel_hi:[1,0,1]
    v_pk_fma_f32 v[46:47], v[54:55], v[96:97], v[46:47] op_sel_hi:[1,0,1]
    v_pk_fma_f32 v[48:49], v[56:57], v[96:97], v[48:49] op_sel_hi:[1,0,1]
    s_waitcnt vmcnt(15)
    v_mov_b32_dpp v96, v25 row_newbcast:12 row_mask:0xf bank_mask:0xf
    v_lshlrev_b32 v50, 16, v160
    v_and_b32 v51, s98, v160
    v_lshlrev_b32 v52, 16, v161
    v_and_b32 v53, s98, v161
    v_lshlrev_b32 v54, 16, v162
    v_and_b32 v55, s98, v162
    v_lshlrev_b32 v56, 16, v163
    v_and_b32 v57, s98, v163
    s_xor_b32 s22, s22, s56
    buffer_load_dwordx4 v[160:163], v1, s[32:35], s22 offen nt
    v_pk_fma_f32 v[42:43], v[50:51], v[96:97], v[42:43] op_sel_hi:[1,0,1]
    v_pk_fma_f32 v[44:45], v[52:53], v[96:97], v[44:45] op_sel_hi:[1,0,1]
    v_pk_fma_f32 v[46:47], v[54:55], v[96:97], v[46:47] op_sel_hi:[1,0,1]
    v_pk_fma_f32 v[48:49], v[56:57], v[96:97], v[48:49] op_sel_hi:[1,0,1]
    s_xor_b32 s63, s63, s54
    s_add_u32 s62, s62, 1
    v_mov_b32 v22, v26
    v_mov_b32 v23, v27
    v_mov_b32 v24, v28
    v_mov_b32 v25, v29
    v_mov_b32 v26, v30
    v_mov_b32 v27, v31
    v_mov_b32 v28, v32
    v_mov_b32 v29, v33
    v_mov_b32 v30, v34
    v_mov_b32 v31, v35
    v_mov_b32 v32, v36
    v_mov_b32 v33, v37
    s_cmp_lt_u32 s62, 3
    s_cbranch_scc1 L_vloop
    s_waitcnt vmcnt(15)
    v_mov_b32_dpp v96, v22 row_newbcast:0 row_mask:0xf bank_mask:0xf
    v_lshlrev_b32 v50, 16, v100
    v_and_b32 v51, s98, v100
    v_lshlrev_b32 v52, 16, v101
    v_and_b32 v53, s98, v101
    v_lshlrev_b32 v54, 16, v102
    v_and_b32 v55, s98, v102
    v_lshlrev_b32 v56, 16, v103
    v_and_b32 v57, s98, v103
    v_pk_fma_f32 v[42:43], v[50:51], v[96:97], v[42:43] op_sel_hi:[1,0,1]
    v_pk_fma_f32 v[44:45], v[52:53], v[96:97], v[44:45] op_sel_hi:[1,0,1]
    v_pk_fma_f32 v[46:47], v[54:55], v[96:97], v[46:47] op_sel_hi:[1,0,1]
    v_pk_fma_f32 v[48:49], v[56:57], v[96:97], v[48:49] op_sel_hi:[1,0,1]
    s_waitcnt vmcnt(14)
    v_mov_b32_dpp v96, v23 row_newbcast:0 row_mask:0xf bank_mask:0xf
    v_lshlrev_b32 v50, 16, v104
    v_and_b32 v51, s98, v104
    v_lshlrev_b32 v52, 16, v105
    v_and_b32 v53, s98, v105
    v_lshlrev_b32 v54, 16, v106
    v_and_b32 v55, s98, v106
    v_lshlrev_b32 v56, 16, v107
    v_and_b32 v57, s98, v107
    v_pk_fma_f32 v[42:43], v[50:51], v[96:97], v[42:43] op_sel_hi:[1,0,1]
    v_pk_fma_f32 v[44:45], v[52:53], v[96:97], v[44:45] op_sel_hi:[1,0,1]
    v_pk_fma_f32 v[46:47], v[54:55], v[96:97], v[46:47] op_sel_hi:[1,0,1]
    v_pk_fma_f32 v[48:49], v[56:57], v[96:97], v[48:49] op_sel_hi:[1,0,1]
    s_waitcnt vmcnt(13)
    v_mov_b32_dpp v96, v24 row_newbcast:0 row_mask:0xf bank_mask:0xf
    v_lshlrev_b32 v50, 16, v108
    v_and_b32 v51, s98, v108
    v_lshlrev_b32 v52, 16, v109
    v_and_b32 v53, s98, v109
    v_lshlrev_b32 v54, 16, v110
    v_and_b32 v55, s98, v110
    v_lshlrev_b32 v56, 16, v111
    v_and_b32 v57, s98, v111
    v_pk_fma_f32 v[42:43], v[50:51], v[96:97], v[42:43] op_sel_hi:[1,0,1]
    v_pk_fma_f32 v[44:45], v[52:53], v[96:97], v[44:45] op_sel_hi:[1,0,1]
    v_pk_fma_f32 v[46:47], v[54:55], v[96:97], v[46:47] op_sel_hi:[1,0,1]
    v_pk_fma_f32 v[48:49], v[56:57], v[96:97], v[48:49] op_sel_hi:[1,0,1]
    s_waitcnt vmcnt(12)
    v_mov_b32_dpp v96, v25 row_newbcast:0 row_mask:0xf bank_mask:0xf
    v_lshlrev_b32 v50, 16, v112
    v_and_b32 v51, s98, v112
    v_lshlrev_b32 v52, 16, v113
    v_and_b32 v53, s98, v113
    v_lshlrev_b32 v54, 16, v114
    v_and_b32 v55, s98, v114
    v_lshlrev_b32 v56, 16, v115
    v_and_b32 v57, s98, v115
    v_pk_fma_f32 v[42:43], v[50:51], v[96:97], v[42:43] op_sel_hi:[1,0,1]
    v_pk_fma_f32 v[44:45], v[52:53], v[96:97], v[44:45] op_sel_hi:[1,0,1]
    v_pk_fma_f32 v[46:47], v[54:55], v[96:97], v[46:47] op_sel_hi:[1,0,1]
    v_pk_fma_f32 v[48:49], v[56:57], v[96:97], v[48:49] op_sel_hi:[1,0,1]
    s_waitcnt vmcnt(11)
    v_mov_b32_dpp v96, v22 row_newbcast:4 row_mask:0xf bank_mask:0xf
    v_lshlrev_b32 v50, 16, v116
    v_and_b32 v51, s98, v116
    v_lshlrev_b32 v52, 16, v117
    v_and_b32 v53, s98, v117
    v_lshlrev_b32 v54, 16, v118
    v_and_b32 v55, s98, v118
    v_lshlrev_b32 v56, 16, v119
    v_and_b32 v57, s98, v119
    v_pk_fma_f32 v[42:43], v[50:51], v[96:97], v[42:43] op_sel_hi:[1,0,1]
    v_pk_fma_f32 v[44:45], v[52:53], v[96:97], v[44:45] op_sel_hi:[1,0,1]
    v_pk_fma_f32 v[46:47], v[54:55], v[96:97], v[46:47] op_sel_hi:[1,0,1]
    v_pk_fma_f32 v[48:49], v[56:57], v[96:97], v[48:49] op_sel_hi:[1,0,1]
    s_waitcnt vmcnt(10)
    v_mov_b32_dpp v96, v23 row_newbcast:4 row_mask:0xf bank_mask:0xf
    v_lshlrev_b32 v50, 16, v120
    v_and_b32 v51, s98, v120
    v_lshlrev_b32 v52, 16, v121
    v_and_b32 v53, s98, v121
    v_lshlrev_b32 v54, 16, v122
    v_and_b32 v55, s98, v122
    v_lshlrev_b32 v56, 16, v123
    v_and_b32 v57, s98, v123
    v_pk_fma_f32 v[42:43], v[50:51], v[96:97], v[42:43] op_sel_hi:[1,0,1]
    v_pk_fma_f32 v[44:45], v[52:53], v[96:97], v[44:45] op_sel_hi:[1,0,1]
    v_pk_fma_f32 v[46:47], v[54:55], v[96:97], v[46:47] op_sel_hi:[1,0,1]
    v_pk_fma_f32 v[48:49], v[56:57], v[96:97], v[48:49] op_sel_hi:[1,0,1]
    s_waitcnt vmcnt(9)
    v_mov_b32_dpp v96, v24 row_newbcast:4 row_mask:0xf bank_mask:0xf
    v_lshlrev_b32 v50, 16, v124
    v_and_b32 v51, s98, v124
    v_lshlrev_b32 v52, 16, v125
    v_and_b32 v53, s98, v125
    v_lshlrev_b32 v54, 16, v126
    v_and_b32 v55, s98, v126
    v_lshlrev_b32 v56, 16, v127
    v_and_b32 v57, s98, v127
    v_pk_fma_f32 v[42:43], v[50:51], v[96:97], v[42:43] op_sel_hi:[1,0,1]
    v_pk_fma_f32 v[44:45], v[52:53], v[96:97], v[44:45] op_sel_hi:[1,0,1]
    v_pk_fma_f32 v[46:47], v[54:55], v[96:97], v[46:47] op_sel_hi:[1,0,1]
    v_pk_fma_f32 v[48:49], v[56:57], v[96:97], v[48:49] op_sel_hi:[1,0,1]
    s_waitcnt vmcnt(8)
    v_mov_b32_dpp v96, v25 row_newbcast:4 row_mask:0xf bank_mask:0xf
    v_lshlrev_b32 v50, 16, v128
    v_and_b32 v51, s98, v128
    v_lshlrev_b32 v52, 16, v129
    v_and_b32 v53, s98, v129
    v_lshlrev_b32 v54, 16, v130
    v_and_b32 v55, s98, v130
    v_lshlrev_b32 v56, 16, v131
    v_and_b32 v57, s98, v131
    v_pk_fma_f32 v[42:43], v[50:51], v[96:97], v[42:43] op_sel_hi:[1,0,1]
    v_pk_fma_f32 v[44:45], v[52:53], v[96:97], v[44:45] op_sel_hi:[1,0,1]
    v_pk_fma_f32 v[46:47], v[54:55], v[96:97], v[46:47] op_sel_hi:[1,0,1]
    v_pk_fma_f32 v[48:49], v[56:57], v[96:97], v[48:49] op_sel_hi:[1,0,1]
    s_waitcnt vmcnt(7)
    v_mov_b32_dpp v96, v22 row_newbcast:8 row_mask:0xf bank_mask:0xf
    v_lshlrev_b32 v50, 16, v132
    v_and_b32 v51, s98, v132
    v_lshlrev_b32 v52, 16, v133
    v_and_b32 v53, s98, v133
    v_lshlrev_b32 v54, 16, v134
    v_and_b32 v55, s98, v134
    v_lshlrev_b32 v56, 16, v135
    v_and_b32 v57, s98, v135
    v_pk_fma_f32 v[42:43], v[50:51], v[96:97], v[42:43] op_sel_hi:[1,0,1]
    v_pk_fma_f32 v[44:45], v[52:53], v[96:97], v[44:45] op_sel_hi:[1,0,1]
    v_pk_fma_f32 v[46:47], v[54:55], v[96:97], v[46:47] op_sel_hi:[1,0,1]
    v_pk_fma_f32 v[48:49], v[56:57], v[96:97], v[48:49] op_sel_hi:[1,0,1]
    s_waitcnt vmcnt(6)
    v_mov_b32_dpp v96, v23 row_newbcast:8 row_mask:0xf bank_mask:0xf
    v_lshlrev_b32 v50, 16, v136
    v_and_b32 v51, s98, v136
    v_lshlrev_b32 v52, 16, v137
    v_and_b32 v53, s98, v137
    v_lshlrev_b32 v54, 16, v138
    v_and_b32 v55, s98, v138
    v_lshlrev_b32 v56, 16, v139
    v_and_b32 v57, s98, v139
    v_pk_fma_f32 v[42:43], v[50:51], v[96:97], v[42:43] op_sel_hi:[1,0,1]
    v_pk_fma_f32 v[44:45], v[52:53], v[96:97], v[44:45] op_sel_hi:[1,0,1]
    v_pk_fma_f32 v[46:47], v[54:55], v[96:97], v[46:47] op_sel_hi:[1,0,1]
    v_pk_fma_f32 v[48:49], v[56:57], v[96:97], v[48:49] op_sel_hi:[1,0,1]
    s_waitcnt vmcnt(5)
    v_mov_b32_dpp v96, v24 row_newbcast:8 row_mask:0xf bank_mask:0xf
    v_lshlrev_b32 v50, 16, v140
    v_and_b32 v51, s98, v140
    v_lshlrev_b32 v52, 16, v141
    v_and_b32 v53, s98, v141
    v_lshlrev_b32 v54, 16, v142
    v_and_b32 v55, s98, v142
    v_lshlrev_b32 v56, 16, v143
    v_and_b32 v57, s98, v143
    v_pk_fma_f32 v[42:43], v[50:51], v[96:97], v[42:43] op_sel_hi:[1,0,1]
    v_pk_fma_f32 v[44:45], v[52:53], v[96:97], v[44:45] op_sel_hi:[1,0,1]
    v_pk_fma_f32 v[46:47], v[54:55], v[96:97], v[46:47] op_sel_hi:[1,0,1]
    v_pk_fma_f32 v[48:49], v[56:57], v[96:97], v[48:49] op_sel_hi:[1,0,1]
    s_waitcnt vmcnt(4)
    v_mov_b32_dpp v96, v25 row_newbcast:8 row_mask:0xf bank_mask:0xf
    v_lshlrev_b32 v50, 16, v144
    v_and_b32 v51, s98, v144
    v_lshlrev_b32 v52, 16, v145
    v_and_b32 v53, s98, v145
    v_lshlrev_b32 v54, 16, v146
    v_and_b32 v55, s98, v146
    v_lshlrev_b32 v56, 16, v147
    v_and_b32 v57, s98, v147
    v_pk_fma_f32 v[42:43], v[50:51], v[96:97], v[42:43] op_sel_hi:[1,0,1]
    v_pk_fma_f32 v[44:45], v[52:53], v[96:97], v[44:45] op_sel_hi:[1,0,1]
    v_pk_fma_f32 v[46:47], v[54:55], v[96:97], v[46:47] op_sel_hi:[1,0,1]
    v_pk_fma_f32 v[48:49], v[56:57], v[96:97], v[48:49] op_sel_hi:[1,0,1]
    s_waitcnt vmcnt(3)
    v_mov_b32_dpp v96, v22 row_newbcast:12 row_mask:0xf bank_mask:0xf
    v_lshlrev_b32 v50, 16, v148
    v_and_b32 v51, s98, v148
    v_lshlrev_b32 v52, 16, v149
    v_and_b32 v53, s98, v149
    v_lshlrev_b32 v54, 16, v150
    v_and_b32 v55, s98, v150
    v_lshlrev_b32 v56, 16, v151
    v_and_b32 v57, s98, v151
    v_pk_fma_f32 v[42:43], v[50:51], v[96:97], v[42:43] op_sel_hi:[1,0,1]
    v_pk_fma_f32 v[44:45], v[52:53], v[96:97], v[44:45] op_sel_hi:[1,0,1]
    v_pk_fma_f32 v[46:47], v[54:55], v[96:97], v[46:47] op_sel_hi:[1,0,1]
    v_pk_fma_f32 v[48:49], v[56:57], v[96:97], v[48:49] op_sel_hi:[1,0,1]
    s_mov_b32 s3, 0
    s_cmp_lg_u32 s18, 0
    s_cbranch_scc1 L_restr
    v_readfirstlane_b32 s3, v66
    s_nop 0
    s_cmp_lg_u32 s3, -1
    s_cbranch_scc1 L_tkokr
    s_waitcnt vmcnt(0)
    v_readfirstlane_b32 s3, v66
    s_nop 0
L_tkokr:
    s_cmp_lg_u32 s3, 3
    s_cbranch_scc1 L_restr
    v_xor_b32 v62, 1024, v65
    global_load_dwordx4 v[72:75], v62, s[14:15] sc1
    v_xor_b32 v62, 2048, v65
    global_load_dwordx4 v[76:79], v62, s[14:15] sc1
    v_xor_b32 v62, 3072, v65
    global_load_dwordx4 v[80:83], v62, s[14:15] sc1
    s_waitcnt vmcnt(5)
    v_mov_b32_dpp v96, v23 row_newbcast:12 row_mask:0xf bank_mask:0xf
    v_lshlrev_b32 v50, 16, v152
    v_and_b32 v51, s98, v152
    v_lshlrev_b32 v52, 16, v153
    v_and_b32 v53, s98, v153
    v_lshlrev_b32 v54, 16, v154
    v_and_b32 v55, s98, v154
    v_lshlrev_b32 v56, 16, v155
    v_and_b32 v57, s98, v155
    v_pk_fma_f32 v[42:43], v[50:51], v[96:97], v[42:43] op_sel_hi:[1,0,1]
    v_pk_fma_f32 v[44:45], v[52:53], v[96:97], v[44:45] op_sel_hi:[1,0,1]
    v_pk_fma_f32 v[46:47], v[54:55], v[96:97], v[46:47] op_sel_hi:[1,0,1]
    v_pk_fma_f32 v[48:49], v[56:57], v[96:97], v[48:49] op_sel_hi:[1,0,1]
    s_waitcnt vmcnt(4)
    v_mov_b32_dpp v96, v24 row_newbcast:12 row_mask:0xf bank_mask:0xf
    v_lshlrev_b32 v50, 16, v156
    v_and_b32 v51, s98, v156
    v_lshlrev_b32 v52, 16, v157
    v_and_b32 v53, s98, v157
    v_lshlrev_b32 v54, 16, v158
    v_and_b32 v55, s98, v158
    v_lshlrev_b32 v56, 16, v159
    v_and_b32 v57, s98, v159
    v_pk_fma_f32 v[42:43], v[50:51], v[96:97], v[42:43] op_sel_hi:[1,0,1]
    v_pk_fma_f32 v[44:45], v[52:53], v[96:97], v[44:45] op_sel_hi:[1,0,1]
    v_pk_fma_f32 v[46:47], v[54:55], v[96:97], v[46:47] op_sel_hi:[1,0,1]
    v_pk_fma_f32 v[48:49], v[56:57], v[96:97], v[48:49] op_sel_hi:[1,0,1]
    s_waitcnt vmcnt(3)
    v_xor_b32 v62, 1024, v65
    global_load_dwordx4 v[84:87], v62, s[14:15] sc1
    v_xor_b32 v62, 2048, v65
    global_load_dwordx4 v[88:91], v62, s[14:15] sc1
    v_xor_b32 v62, 3072, v65
    global_load_dwordx4 v[92:95], v62, s[14:15] sc1
    v_mov_b32_dpp v96, v25 row_newbcast:12 row_mask:0xf bank_mask:0xf
    v_lshlrev_b32 v50, 16, v160
    v_and_b32 v51, s98, v160
    v_lshlrev_b32 v52, 16, v161
    v_and_b32 v53, s98, v161
    v_lshlrev_b32 v54, 16, v162
    v_and_b32 v55, s98, v162
    v_lshlrev_b32 v56, 16, v163
    v_and_b32 v57, s98, v163
    v_pk_fma_f32 v[42:43], v[50:51], v[96:97], v[42:43] op_sel_hi:[1,0,1]
    v_pk_fma_f32 v[44:45], v[52:53], v[96:97], v[44:45] op_sel_hi:[1,0,1]
    v_pk_fma_f32 v[46:47], v[54:55], v[96:97], v[46:47] op_sel_hi:[1,0,1]
    v_pk_fma_f32 v[48:49], v[56:57], v[96:97], v[48:49] op_sel_hi:[1,0,1]
    s_branch L_vdone
L_restr:
    s_waitcnt vmcnt(2)
    v_mov_b32_dpp v96, v23 row_newbcast:12 row_mask:0xf bank_mask:0xf
    v_lshlrev_b32 v50, 16, v152
    v_and_b32 v51, s98, v152
    v_lshlrev_b32 v52, 16, v153
    v_and_b32 v53, s98, v153
    v_lshlrev_b32 v54, 16, v154
    v_and_b32 v55, s98, v154
    v_lshlrev_b32 v56, 16, v155
    v_and_b32 v57, s98, v155
    v_pk_fma_f32 v[42:43], v[50:51], v[96:97], v[42:43] op_sel_hi:[1,0,1]
    v_pk_fma_f32 v[44:45], v[52:53], v[96:97], v[44:45] op_sel_hi:[1,0,1]
    v_pk_fma_f32 v[46:47], v[54:55], v[96:97], v[46:47] op_sel_hi:[1,0,1]
    v_pk_fma_f32 v[48:49], v[56:57], v[96:97], v[48:49] op_sel_hi:[1,0,1]
    s_waitcnt vmcnt(1)
    v_mov_b32_dpp v96, v24 row_newbcast:12 row_mask:0xf bank_mask:0xf
    v_lshlrev_b32 v50, 16, v156
    v_and_b32 v51, s98, v156
    v_lshlrev_b32 v52, 16, v157
    v_and_b32 v53, s98, v157
    v_lshlrev_b32 v54, 16, v158
    v_and_b32 v55, s98, v158
    v_lshlrev_b32 v56, 16, v159
    v_and_b32 v57, s98, v159
    v_pk_fma_f32 v[42:43], v[50:51], v[96:97], v[42:43] op_sel_hi:[1,0,1]
    v_pk_fma_f32 v[44:45], v[52:53], v[96:97], v[44:45] op_sel_hi:[1,0,1]
    v_pk_fma_f32 v[46:47], v[54:55], v[96:97], v[46:47] op_sel_hi:[1,0,1]
    v_pk_fma_f32 v[48:49], v[56:57], v[96:97], v[48:49] op_sel_hi:[1,0,1]
    s_waitcnt vmcnt(0)
    v_mov_b32_dpp v96, v25 row_newbcast:12 row_mask:0xf bank_mask:0xf
    v_lshlrev_b32 v50, 16, v160
    v_and_b32 v51, s98, v160
    v_lshlrev_b32 v52, 16, v161
    v_and_b32 v53, s98, v161
    v_lshlrev_b32 v54, 16, v162
    v_and_b32 v55, s98, v162
    v_lshlrev_b32 v56, 16, v163
    v_and_b32 v57, s98, v163
    v_pk_fma_f32 v[42:43], v[50:51], v[96:97], v[42:43] op_sel_hi:[1,0,1]
    v_pk_fma_f32 v[44:45], v[52:53], v[96:97], v[44:45] op_sel_hi:[1,0,1]
    v_pk_fma_f32 v[46:47], v[54:55], v[96:97], v[46:47] op_sel_hi:[1,0,1]
    v_pk_fma_f32 v[48:49], v[56:57], v[96:97], v[48:49] op_sel_hi:[1,0,1]
L_vdone:
    s_nop 1
    v_permlane32_swap_b32 v42, v46
    v_permlane32_swap_b32 v43, v47
    v_permlane32_swap_b32 v44, v48
    v_permlane32_swap_b32 v45, v49
    s_nop 0
    v_add_f32 v42, v42, v46
    v_add_f32 v43, v43, v47
    v_add_f32 v44, v44, v48
    v_add_f32 v45, v45, v49
    s_nop 1
    v_permlane16_swap_b32 v42, v44
    v_permlane16_swap_b32 v43, v45
    s_nop 0
    v_add_f32 v50, v42, v44
    v_add_f32 v51, v43, v45
    v_mul_f32 v50, v50, v60
    v_mul_f32 v51, v51, v60
    ds_write_b64 v64, v[50:51]
    s_cmp_lg_u32 s18, 0
    s_cbranch_scc1 L_bar_exit
    v_lshlrev_b32 v61, 3, v0
    s_cmp_lg_u32 s3, 3
    s_cbranch_scc1 L_producer
    s_mov_b32 s96, 0
    s_waitcnt vmcnt(3)
    v_cmp_ne_u32 vcc, 0, v75
    v_cmp_ne_u32 s[4:5], 0, v79
    v_cmp_ne_u32 s[6:7], 0, v83
    s_nop 1
    s_and_b64 vcc, vcc, s[4:5]
    s_and_b64 vcc, vcc, s[6:7]
    s_cmp_eq_u64 vcc, -1
    s_cbranch_scc1 L_fast
    s_waitcnt lgkmcnt(0)
    s_barrier
    ds_read_b64 v[100:101], v61 offset:0
    ds_read_b64 v[102:103], v61 offset:512
    ds_read_b64 v[104:105], v61 offset:1024
    ds_read_b64 v[106:107], v61 offset:1536
    v_xor_b32 v62, 1024, v65
    global_load_dwordx4 v[72:75], v62, s[14:15] sc1
    v_xor_b32 v62, 2048, v65
    global_load_dwordx4 v[76:79], v62, s[14:15] sc1
    v_xor_b32 v62, 3072, v65
    global_load_dwordx4 v[80:83], v62, s[14:15] sc1
    s_waitcnt lgkmcnt(2)
    v_add_f32 v100, v100, v102
    v_add_f32 v101, v101, v103
    s_waitcnt lgkmcnt(0)
    v_add_f32 v104, v104, v106
    v_add_f32 v105, v105, v107
    v_add_f32 v100, v100, v104
    v_add_f32 v101, v101, v105
L_poll:
    s_waitcnt vmcnt(3)
    v_cmp_ne_u32 vcc, 0, v87
    v_cmp_ne_u32 s[4:5], 0, v91
    v_cmp_ne_u32 s[6:7], 0, v95
    s_nop 1
    s_and_b64 vcc, vcc, s[4:5]
    s_and_b64 vcc, vcc, s[6:7]
    s_cmp_eq_u64 vcc, -1
    s_cbranch_scc1 L_finB
    s_add_u32 s96, s96, 1
    s_cmp_ge_u32 s96, 1048576
    s_cbranch_scc1 L_finB
    v_xor_b32 v62, 1024, v65
    global_load_dwordx4 v[84:87], v62, s[14:15] sc1
    v_xor_b32 v62, 2048, v65
    global_load_dwordx4 v[88:91], v62, s[14:15] sc1
    v_xor_b32 v62, 3072, v65
    global_load_dwordx4 v[92:95], v62, s[14:15] sc1
    s_waitcnt vmcnt(3)
    v_cmp_ne_u32 vcc, 0, v75
    v_cmp_ne_u32 s[4:5], 0, v79
    v_cmp_ne_u32 s[6:7], 0, v83
    s_nop 1
    s_and_b64 vcc, vcc, s[4:5]
    s_and_b64 vcc, vcc, s[6:7]
    s_cmp_eq_u64 vcc, -1
    s_cbranch_scc1 L_finA
    v_xor_b32 v62, 1024, v65
    global_load_dwordx4 v[72:75], v62, s[14:15] sc1
    v_xor_b32 v62, 2048, v65
    global_load_dwordx4 v[76:79], v62, s[14:15] sc1
    v_xor_b32 v62, 3072, v65
    global_load_dwordx4 v[80:83], v62, s[14:15] sc1
    s_branch L_poll
L_finB:
    v_max_f32 v6, v67, v86
    v_max3_f32 v6, v6, v90, v94
    v_sub_f32 v7, v67, v6
    v_sub_f32 v8, v86, v6
    v_sub_f32 v9, v90, v6
    v_sub_f32 v10, v94, v6
    v_exp_f32 v7, v7
    v_exp_f32 v8, v8
    v_exp_f32 v9, v9
    v_exp_f32 v10, v10
    s_lshl_b32 s19, s16, 8
    v_mul_f32 v11, v7, v68
    v_mul_f32 v12, v8, v87
    v_mul_f32 v13, v9, v91
    v_mul_f32 v14, v10, v95
    v_add_f32 v11, v11, v12
    v_add_f32 v13, v13, v14
    v_mul_f32 v15, v8, v84
    v_add_f32 v11, v11, v13
    v_mul_f32 v16, v8, v85
    v_rcp_f32 v11, v11
    v_mul_f32 v17, v9, v88
    v_mul_f32 v18, v9, v89
    v_mul_f32 v19, v10, v92
    v_mul_f32 v20, v10, v93
    v_add_u32 v63, s19, v69
    v_add_f32 v17, v17, v19
    v_add_f32 v18, v18, v20
    v_mul_f32 v100, v7, v100
    v_mul_f32 v101, v7, v101
    v_add_f32 v100, v100, v15
    v_add_f32 v101, v101, v16
    v_add_f32 v100, v100, v17
    v_add_f32 v101, v101, v18
    v_mul_f32 v100, v100, v11
    v_mul_f32 v101, v101, v11
    v_cvt_pk_bf16_f32 v12, v100, v101
    global_store_dword v63, v12, s[10:11]
    s_branch L_end
L_finA:
    v_max_f32 v6, v67, v74
    v_max3_f32 v6, v6, v78, v82
    v_sub_f32 v7, v67, v6
    v_sub_f32 v8, v74, v6
    v_sub_f32 v9, v78, v6
    v_sub_f32 v10, v82, v6
    v_exp_f32 v7, v7
    v_exp_f32 v8, v8
    v_exp_f32 v9, v9
    v_exp_f32 v10, v10
    s_lshl_b32 s19, s16, 8
    v_mul_f32 v11, v7, v68
    v_mul_f32 v12, v8, v75
    v_mul_f32 v13, v9, v79
    v_mul_f32 v14, v10, v83
    v_add_f32 v11, v11, v12
    v_add_f32 v13, v13, v14
    v_mul_f32 v15, v8, v72
    v_add_f32 v11, v11, v13
    v_mul_f32 v16, v8, v73
    v_rcp_f32 v11, v11
    v_mul_f32 v17, v9, v76
    v_mul_f32 v18, v9, v77
    v_mul_f32 v19, v10, v80
    v_mul_f32 v20, v10, v81
    v_add_u32 v63, s19, v69
    v_add_f32 v17, v17, v19
    v_add_f32 v18, v18, v20
    v_mul_f32 v100, v7, v100
    v_mul_f32 v101, v7, v101
    v_add_f32 v100, v100, v15
    v_add_f32 v101, v101, v16
    v_add_f32 v100, v100, v17
    v_add_f32 v101, v101, v18
    v_mul_f32 v100, v100, v11
    v_mul_f32 v101, v101, v11
    v_cvt_pk_bf16_f32 v12, v100, v101
    global_store_dword v63, v12, s[10:11]
    s_branch L_end
L_fast:
    v_max_f32 v6, v67, v74
    v_max3_f32 v6, v6, v78, v82
    v_sub_f32 v7, v67, v6
    v_sub_f32 v8, v74, v6
    v_sub_f32 v9, v78, v6
    v_sub_f32 v10, v82, v6
    v_exp_f32 v7, v7
    v_exp_f32 v8, v8
    v_exp_f32 v9, v9
    v_exp_f32 v10, v10
    s_lshl_b32 s19, s16, 8
    v_mul_f32 v11, v7, v68
    v_mul_f32 v12, v8, v75
    v_mul_f32 v13, v9, v79
    v_mul_f32 v14, v10, v83
    v_add_f32 v11, v11, v12
    v_add_f32 v13, v13, v14
    v_mul_f32 v15, v8, v72
    v_add_f32 v11, v11, v13
    v_mul_f32 v16, v8, v73
    v_rcp_f32 v11, v11
    v_mul_f32 v17, v9, v76
    v_mul_f32 v18, v9, v77
    v_mul_f32 v19, v10, v80
    v_mul_f32 v20, v10, v81
    v_add_u32 v63, s19, v69
    v_add_f32 v17, v17, v19
    v_add_f32 v18, v18, v20
    s_waitcnt lgkmcnt(0)
    s_barrier
    ds_read_b64 v[100:101], v61 offset:0
    ds_read_b64 v[102:103], v61 offset:512
    ds_read_b64 v[104:105], v61 offset:1024
    ds_read_b64 v[106:107], v61 offset:1536
    s_waitcnt lgkmcnt(2)
    v_add_f32 v100, v100, v102
    v_add_f32 v101, v101, v103
    s_waitcnt lgkmcnt(0)
    v_add_f32 v104, v104, v106
    v_add_f32 v105, v105, v107
    v_add_f32 v100, v100, v104
    v_add_f32 v101, v101, v105
    v_mul_f32 v100, v7, v100
    v_mul_f32 v101, v7, v101
    v_add_f32 v100, v100, v15
    v_add_f32 v101, v101, v16
    v_add_f32 v100, v100, v17
    v_add_f32 v101, v101, v18
    v_mul_f32 v100, v100, v11
    v_mul_f32 v101, v101, v11
    v_cvt_pk_bf16_f32 v12, v100, v101
    global_store_dword v63, v12, s[10:11]
    s_branch L_end
L_producer:
    s_waitcnt lgkmcnt(0)
    s_barrier
    ds_read_b64 v[100:101], v61 offset:0
    ds_read_b64 v[102:103], v61 offset:512
    ds_read_b64 v[104:105], v61 offset:1024
    ds_read_b64 v[106:107], v61 offset:1536
    v_mov_b32 v74, v67
    v_mov_b32 v75, v68
    s_waitcnt lgkmcnt(2)
    v_add_f32 v100, v100, v102
    v_add_f32 v101, v101, v103
    s_waitcnt lgkmcnt(0)
    v_add_f32 v104, v104, v106
    v_add_f32 v105, v105, v107
    v_add_f32 v72, v100, v104
    v_add_f32 v73, v101, v105
    global_store_dwordx4 v65, v[72:75], s[14:15] sc1
    s_branch L_end
L_bar_exit:
    s_waitcnt lgkmcnt(0)
    s_barrier
L_end:
L_exit:
    s_endpgm
.section .rodata,"a"
.p2align 6
.amdhsa_kernel standalone__gqa_softmax__decode_kernel
  .amdhsa_next_free_vgpr 168
  .amdhsa_next_free_sgpr 100
  .amdhsa_accum_offset 168
  .amdhsa_group_segment_fixed_size 0
  .amdhsa_kernarg_size 48
  .amdhsa_user_sgpr_count 2
  .amdhsa_user_sgpr_kernarg_segment_ptr 1
  .amdhsa_system_sgpr_workgroup_id_x 1
  .amdhsa_float_denorm_mode_32 3
.end_amdhsa_kernel
```
